```python
import torch

def _softmax(x, axis=-1):
    return torch.softmax(x, dim=axis)
def _gelu(x):
    return torch.nn.functional.gelu(x, approximate="tanh")
def _silu(x):
    return torch.nn.functional.silu(x)
def _sigmoid(x):
    return torch.sigmoid(x)
def _layernorm(x, axis=-1, eps=1e-5):
    m = x.mean(dim=axis, keepdim=True)
    v = x.var(dim=axis, keepdim=True, unbiased=False)
    return (x - m) / torch.sqrt(v + eps)
def _scatter_add(tgt, idx, src, axis=0):
    return tgt.clone().index_add_(axis, idx, src)
def _segment_sum(src, seg, n):
    out = torch.zeros((n,) + src.shape[1:], dtype=src.dtype)
    return out.index_add_(0, seg, src)
def _pad(x, pw):
    flat = tuple(v for pair in reversed(pw) for v in pair)
    return torch.nn.functional.pad(x, flat)

kernel_name = 'recurrent_scan__sliding_block_cached__swiglu_ffn__decode'

def setup_inputs():

    _w = (lambda a: (lambda t: t.to(torch.bfloat16) if t.is_floating_point() else t)(torch.as_tensor(a)))
    def _A_setup():
        B, Sq, D = 4, 1, 512
        Hq, Hkv, Sk, Dh = 32, 8, 8192, 128
        assert Hq % Hkv == 0, (Hq, Hkv)
        return {
            "x": _w((lambda *s: torch.randn(*s, dtype=torch.bfloat16) * 0.05)(B, Sq, D)),
            "k_cache": _w((lambda *s: torch.randn(*s, dtype=torch.bfloat16) * 1.6)(B, Hkv, Sk, Dh)),
            "v_cache": _w((lambda *s: torch.randn(*s, dtype=torch.bfloat16) * 0.2)(B, Hkv, Sk, Dh)),
            "wq": _w((lambda *s: torch.randn(*s, dtype=torch.bfloat16) * 1.6)(D, Hq * Dh) * (D ** -0.5)),
            "wo": _w((lambda *s: torch.randn(*s, dtype=torch.bfloat16) * 0.2)(Hq * Dh, D) * ((Hq * Dh) ** -0.5)),
        }
    _A_in = _A_setup()

    def _B_setup():
        B, S, D, F = 4, 1, 512, 1792
        return {
            "x": _w((lambda *s: torch.randn(*s, dtype=torch.bfloat16) * 0.05)(B, S, D)),
            "w_gate": _w((lambda *s: torch.randn(*s, dtype=torch.bfloat16) * 0.1)(D, F)),
            "w_up": _w((lambda *s: torch.randn(*s, dtype=torch.bfloat16) * 0.1)(D, F)),
            "w_down": _w((lambda *s: torch.randn(*s, dtype=torch.bfloat16) * 0.1)(F, D)),
        }
    _B_in = _B_setup()

    return {
        "A_x": _A_in["x"],
        "A_k_cache": _A_in["k_cache"],
        "A_v_cache": _A_in["v_cache"],
        "A_wq": _A_in["wq"],
        "A_wo": _A_in["wo"],
        "B_x": _B_in["x"],
        "B_w_gate": _B_in["w_gate"],
        "B_w_up": _B_in["w_up"],
        "B_w_down": _B_in["w_down"],
    }

def reference(A_x, A_k_cache, A_v_cache, A_wq, A_wo, B_x, B_w_gate, B_w_up, B_w_down):
    def _A_ref(x, k_cache, v_cache, wq, wo):
        B, Sq, D = x.shape
        Hq, Dh = 32, 128
        Hkv, Sk = k_cache.shape[1], k_cache.shape[2]
        W = min(4096, max(256, Sk // 4))
        rep = Hq // Hkv
        q = (lambda x, *d: x.permute(*d))((x @ wq).reshape(B, Sq, Hq, Dh), 0, 2, 1, 3)
        k = (lambda x, n, axis: torch.repeat_interleave(x, n, dim=axis))(k_cache[:, :, Sk - W:, :], rep, axis=1)
        v = (lambda x, n, axis: torch.repeat_interleave(x, n, dim=axis))(v_cache[:, :, Sk - W:, :], rep, axis=1)
        scores = torch.einsum("bhqd,bhkd->bhqk", q, k) * (Dh ** -0.5)
        p = _softmax(scores, axis=-1)
        o = torch.einsum("bhqk,bhkd->bhqd", p, v)
        return (lambda x, *d: x.permute(*d))(o, 0, 2, 1, 3).reshape(B, Sq, Hq * Dh) @ wo

    def _B_ref(x, w_gate, w_up, w_down):
        g = _silu(x @ w_gate)
        u = x @ w_up
        return (g * u) @ w_down

    x = A_x
    xn = _layernorm(x, axis=-1)
    s = _A_ref(xn, A_k_cache, A_v_cache, A_wq, A_wo)
    g = _silu(_B_ref(xn, B_w_gate, B_w_up, B_w_down))
    return x + s * g
```

```asm
; @launch grid=(256,1,1) block=(704,1,1) lds=163840
.amdgcn_target "amdgcn-amd-amdhsa--gfx950"
.text
.globl recurrent_scan__sliding_block_cached__swiglu_ffn__decode_kernel
.p2align 8
.type recurrent_scan__sliding_block_cached__swiglu_ffn__decode_kernel,@function
recurrent_scan__sliding_block_cached__swiglu_ffn__decode_kernel:
    s_cmp_ge_u32 s2, 256
    s_cbranch_scc1 L_end
    s_load_dwordx16 s[4:19], s[0:1], 0
    s_load_dwordx8 s[20:27], s[0:1], 64

    s_getpc_b64 s[70:71]
L_pc:
    v_lshlrev_b32 v14, 4, v0
    v_min_u32 v14, L_end-L_pc-1024-16, v14
    global_load_dwordx4 v[4:7], v14, s[70:71] offset:1024

    v_lshrrev_b32 v14, 6, v0
    v_and_b32 v8, 63, v0
    v_readfirstlane_b32 s3, v14
    v_lshrrev_b32 v9, 4, v8
    v_and_b32 v10, 15, v8
    v_and_b32 v11, 3, v8
    v_and_b32 v12, 7, v8
    v_lshrrev_b32 v18, 3, v8
    s_and_b32 s61, s2, 31
    s_lshr_b32 s62, s2, 5
    s_bfe_u32 s63, s2, 0x20001
    s_lshr_b32 s64, s2, 3
    s_and_b32 s68, s2, 7
    s_sub_u32 s65, s3, 1
    s_bfe_u32 s66, s2, 0x30003
    s_lshl3_add_u32 s66, s68, s66
    s_lshr_b32 s67, s2, 6
    s_cmp_lg_u32 s3, 0
    s_cbranch_scc1 L_awave

    v_mov_b32 v38, 0
    v_lshl_add_u32 v37, v10, 2, v38
    v_add_u32 v37, 163584, v37
    v_cmp_eq_u32 vcc, 0, v10
    v_cndmask_b32 v38, v38, -16, vcc
    ds_write_b32 v37, v38
    v_lshlrev_b32 v17, 4, v8
    v_and_b32 v16, 1, v9
    v_lshlrev_b32 v16, 1, v16
    v_xor_b32 v15, v12, v16
    v_lshlrev_b32 v15, 4, v15
    v_xor_b32 v16, 64, v15
    v_lshl_add_u32 v19, v18, 13, v15
    v_lshl_add_u32 v20, v18, 13, v16
    v_add_u32 v20, 64512, v20
    v_add_u32 v21, 129024, v19
    v_add_u32 v22, 129024, v20
    s_mov_b32 m0, 147456

    s_lshl_b32 s55, s66, 7
    s_lshl_b32 s60, s67, 20
    s_add_u32 s55, s55, s60
    s_waitcnt lgkmcnt(0)
    s_mov_b32 s36, s4
    s_mov_b32 s37, s5
    s_mov_b32 s38, 4096
    s_mov_b32 s39, 0x20000
    buffer_load_dwordx4 v17, s[36:39], 0 offen offset:0 lds
    buffer_load_dwordx4 v17, s[36:39], 0 offen offset:1024 lds
    buffer_load_dwordx4 v17, s[36:39], 0 offen offset:2048 lds
    buffer_load_dwordx4 v17, s[36:39], 0 offen offset:3072 lds
    s_mov_b32 m0, 131072
    s_mov_b32 s32, s10
    s_mov_b32 s33, s11
    s_mov_b32 s34, 4194304
    s_mov_b32 s35, 0x20000
    s_add_u32 s56, s55, 1048576
L_ld_1:
    buffer_load_dwordx4 v19, s[32:35], s55 offen offset:0 nt lds
    buffer_load_dwordx4 v20, s[32:35], s55 offen offset:1024 nt lds
    buffer_load_dwordx4 v21, s[32:35], s55 offen offset:2048 nt lds
    buffer_load_dwordx4 v22, s[32:35], s55 offen offset:3072 nt lds
    s_add_u32 s55, s55, 262144
    s_add_u32 m0, m0, 4096
    s_cmp_lg_u32 s55, s56
    s_cbranch_scc1 L_ld_1
    v_mul_u32_u24 v14, 3584, v18
    v_add_u32 v23, v14, v15
    v_add_u32 v24, v14, v16
    v_add_u32 v24, 27648, v24
    v_add_u32 v25, 55296, v23
    v_add_u32 v26, 55296, v24
    s_and_b32 s56, s2, 1
    s_cmp_eq_u32 s56, 0
    s_cselect_b32 s36, s16, s18
    s_cselect_b32 s37, s17, s19
    s_mov_b32 s38, 1835008
    s_mov_b32 s39, 0x20000
    v_mov_b32 v37, 163584
    v_mov_b32 v38, -4

    s_mul_i32 s55, s63, 458752
    s_lshl_b32 s60, s64, 7
    s_add_u32 s55, s55, s60
    s_cmp_ge_u32 s2, 224
    s_cselect_b32 s55, 0x1000000, s55
    s_barrier
    s_mov_b32 m0, 114688
    s_add_u32 s56, s55, 458752
L_ld_2:
    s_waitcnt vmcnt(28)
    v_add_u32 v38, 1, v38
    ds_write_b32 v37, v38
    buffer_load_dwordx4 v23, s[36:39], s55 offen offset:0 nt lds
    buffer_load_dwordx4 v24, s[36:39], s55 offen offset:1024 nt lds
    buffer_load_dwordx4 v25, s[36:39], s55 offen offset:2048 nt lds
    buffer_load_dwordx4 v26, s[36:39], s55 offen offset:3072 nt lds
    s_add_u32 s55, s55, 114688
    s_add_u32 m0, m0, 4096
    s_cmp_lg_u32 s55, s56
    s_cbranch_scc1 L_ld_2
    v_lshl_add_u32 v33, v18, 10, v15
    v_lshl_add_u32 v34, v18, 10, v16
    v_add_u32 v34, 7168, v34
    v_add_u32 v35, 14336, v33
    v_add_u32 v36, 14336, v34
    v_lshlrev_b32 v16, 1, v9
    v_xor_b32 v15, v10, v16
    v_lshlrev_b32 v15, 4, v15
    v_xor_b32 v17, 128, v15
    v_lshl_add_u32 v31, v9, 8, v15
    v_lshl_add_u32 v32, v9, 8, v17
    v_xor_b32 v15, v10, v9
    v_lshlrev_b32 v15, 4, v15
    v_lshl_add_u32 v27, v9, 8, v15
    v_xor_b32 v28, 64, v27
    v_xor_b32 v29, 128, v27
    v_xor_b32 v30, 192, v27

    s_mov_b32 s40, s6
    s_mov_b32 s41, s7
    s_mov_b32 s42, 67108864
    s_mov_b32 s43, 0x20000
    s_mov_b32 s44, s8
    s_mov_b32 s45, s9
    s_mov_b32 s46, 67108864
    s_mov_b32 s47, 0x20000
    s_lshl_b32 s57, s61, 21
    s_lshl_b32 s60, s62, 16
    s_add_u32 s57, s57, s60
    s_add_u32 s57, s57, 1572864
    s_mov_b32 s55, s57
    s_mov_b32 m0, 0
    s_add_u32 s56, s55, 65536
L_ld_3:
    s_waitcnt vmcnt(28)
    v_add_u32 v38, 1, v38
    ds_write_b32 v37, v38
    buffer_load_dwordx4 v27, s[40:43], s55 offen offset:0 nt lds
    buffer_load_dwordx4 v28, s[40:43], s55 offen offset:1024 nt lds
    buffer_load_dwordx4 v29, s[40:43], s55 offen offset:2048 nt lds
    buffer_load_dwordx4 v30, s[40:43], s55 offen offset:3072 nt lds
    s_add_u32 s55, s55, 4096
    s_add_u32 m0, m0, 4096
    s_cmp_lg_u32 s55, s56
    s_cbranch_scc1 L_ld_3
    s_mov_b32 s32, s20
    s_mov_b32 s33, s21
    s_mov_b32 s34, 1835008
    s_mov_b32 s35, 0x20000
    s_mov_b32 s36, s12
    s_mov_b32 s37, s13
    s_mov_b32 s38, 4194304
    s_mov_b32 s39, 0x20000
    s_lshl_b32 s55, s64, 16
    s_lshl_b32 s60, s68, 7
    s_add_u32 s55, s55, s60
    s_mov_b32 m0, 65536
    s_add_u32 s56, s57, 49152
L_ld_4:
    s_waitcnt vmcnt(28)
    v_add_u32 v38, 1, v38
    ds_write_b32 v37, v38
    buffer_load_dwordx4 v31, s[44:47], s57 offen offset:0 nt lds
    buffer_load_dwordx4 v32, s[44:47], s57 offen offset:1024 nt lds
    buffer_load_dwordx4 v31, s[44:47], s57 offen offset:2048 nt lds
    buffer_load_dwordx4 v32, s[44:47], s57 offen offset:3072 nt lds
    s_add_u32 s57, s57, 4096
    s_add_u32 m0, m0, 4096
    s_cmp_lg_u32 s57, s56
    s_cbranch_scc1 L_ld_4
    v_mov_b32 v14, 163592
    s_mov_b32 s59, 400000
L_wfree_5:
    ds_read_b32 v15, v14
    s_sub_u32 s59, s59, 1
    s_waitcnt lgkmcnt(0)
    v_readfirstlane_b32 s56, v15
    s_cselect_b32 s56, 10, s56
    s_cmp_lt_u32 s56, 10
    s_cbranch_scc1 L_wfree_5

    s_add_u32 s56, s57, 16384
L_ld_6:
    s_waitcnt vmcnt(28)
    v_add_u32 v38, 1, v38
    ds_write_b32 v37, v38
    buffer_load_dwordx4 v31, s[44:47], s57 offen offset:0 nt lds
    buffer_load_dwordx4 v32, s[44:47], s57 offen offset:1024 nt lds
    buffer_load_dwordx4 v31, s[44:47], s57 offen offset:2048 nt lds
    buffer_load_dwordx4 v32, s[44:47], s57 offen offset:3072 nt lds
    s_add_u32 s57, s57, 4096
    s_add_u32 m0, m0, 4096
    s_cmp_lg_u32 s57, s56
    s_cbranch_scc1 L_ld_6
    s_lshl_b32 s57, s68, 19
    s_bfe_u32 s60, s64, 0x20000
    s_lshl_b32 s60, s60, 17
    s_add_u32 s57, s57, s60
    s_bfe_u32 s60, s64, 0x30002
    s_lshl_b32 s60, s60, 7
    s_add_u32 s57, s57, s60
    s_mov_b32 m0, 147456
    s_add_u32 s56, s55, 65536
L_ld_7:
    s_waitcnt vmcnt(28)
    v_add_u32 v38, 1, v38
    ds_write_b32 v37, v38
    buffer_load_dwordx4 v33, s[32:35], s55 offen offset:0 nt lds
    buffer_load_dwordx4 v34, s[32:35], s55 offen offset:1024 nt lds
    buffer_load_dwordx4 v35, s[32:35], s55 offen offset:2048 nt lds
    buffer_load_dwordx4 v36, s[32:35], s55 offen offset:3072 nt lds
    s_add_u32 s55, s55, 32768
    s_add_u32 m0, m0, 4096
    s_cmp_lg_u32 s55, s56
    s_cbranch_scc1 L_ld_7
    s_mov_b32 m0, 131072
    s_add_u32 s56, s57, 131072
L_ld_8:
    s_waitcnt vmcnt(28)
    v_add_u32 v38, 1, v38
    ds_write_b32 v37, v38
    buffer_load_dwordx4 v33, s[36:39], s57 offen offset:0 nt lds
    buffer_load_dwordx4 v34, s[36:39], s57 offen offset:1024 nt lds
    buffer_load_dwordx4 v35, s[36:39], s57 offen offset:2048 nt lds
    buffer_load_dwordx4 v36, s[36:39], s57 offen offset:3072 nt lds
    s_add_u32 s57, s57, 32768
    s_add_u32 m0, m0, 4096
    s_cmp_lg_u32 s57, s56
    s_cbranch_scc1 L_ld_8
    s_waitcnt vmcnt(28)
    v_add_u32 v38, 1, v38
    ds_write_b32 v37, v38
    s_waitcnt vmcnt(24)
    v_add_u32 v38, 1, v38
    ds_write_b32 v37, v38
    s_waitcnt vmcnt(20)
    v_add_u32 v38, 1, v38
    ds_write_b32 v37, v38
    s_waitcnt vmcnt(16)
    v_add_u32 v38, 1, v38
    ds_write_b32 v37, v38
    s_waitcnt vmcnt(12)
    v_add_u32 v38, 1, v38
    ds_write_b32 v37, v38
    s_waitcnt vmcnt(8)
    v_add_u32 v38, 1, v38
    ds_write_b32 v37, v38
    s_waitcnt vmcnt(4)
    v_add_u32 v38, 1, v38
    ds_write_b32 v37, v38
    s_waitcnt vmcnt(0)
    v_add_u32 v38, 1, v38
    ds_write_b32 v37, v38
    s_endpgm
L_awave:
    s_lshl_b32 s55, s65, 10
    v_lshlrev_b32 v14, 4, v8
    s_waitcnt lgkmcnt(0)

    s_mov_b32 s32, s4
    s_mov_b32 s33, s5
    s_mov_b32 s34, 4096
    s_mov_b32 s35, 0x20000
    s_add_u32 s55, s55, 147456
    v_add_u32 v17, s55, v14
    s_load_dword s48, s[26:27], 0
    s_lshl_b32 s55, s68, 7
    s_lshl_b32 s60, s64, 2
    s_add_u32 s55, s55, s60
    v_and_b32 v15, 1, v8
    v_lshlrev_b32 v29, 10, v9
    v_lshl_add_u32 v29, v15, 1, v29
    v_add_u32 v29, s55, v29
    s_mov_b32 s28, s26
    s_mov_b32 s29, s27
    s_mov_b32 s30, 268435456
    s_mov_b32 s31, 0x20000
    s_mov_b32 s36, s22
    s_mov_b32 s37, s23
    s_mov_b32 s38, 4096
    s_mov_b32 s39, 0x20000
    v_mov_b32 v19, 1
    s_mov_b32 s69, -16
    v_mov_b32 v20, 0xfffffc00
    s_mov_b32 s53, 0x200
    v_mov_b32 v14, 0

    s_barrier
    s_cmp_ge_u32 s65, 4
    s_cbranch_scc1 L_noln_9
    s_mul_i32 s55, s65, 1088
    s_add_u32 s55, s55, 155648
    v_lshlrev_b32 v14, 4, v8
    v_add_u32 v14, s55, v14
    s_cmp_ge_i32 s69, 0
    s_cbranch_scc1 L_ws_11
    v_mov_b32 v21, 163584
    s_mov_b32 s59, 400000
L_w_10:
    ds_read_b32 v22, v21
    s_sub_u32 s59, s59, 1
    s_waitcnt lgkmcnt(0)
    v_readfirstlane_b32 s69, v22
    s_cselect_b32 s69, 64, s69
    s_cmp_lt_i32 s69, 0
    s_cbranch_scc1 L_w_10

L_ws_11:
    ds_read_b128 v[24:27], v17
    s_waitcnt lgkmcnt(0)
    v_lshlrev_b32 v30, 16, v24
    v_and_b32 v31, 0xffff0000, v24
    v_lshlrev_b32 v32, 16, v25
    v_and_b32 v33, 0xffff0000, v25
    v_lshlrev_b32 v34, 16, v26
    v_and_b32 v35, 0xffff0000, v26
    v_lshlrev_b32 v36, 16, v27
    v_and_b32 v37, 0xffff0000, v27
    v_add_f32 v38, v30, v31
    v_add_f32 v38, v38, v32
    v_add_f32 v38, v38, v33
    v_add_f32 v38, v38, v34
    v_add_f32 v38, v38, v35
    v_add_f32 v38, v38, v36
    v_add_f32 v38, v38, v37
    s_nop 1
    v_add_f32_dpp v38, v38, v38 row_ror:8 row_mask:0xf bank_mask:0xf
    s_nop 1
    v_add_f32_dpp v38, v38, v38 row_ror:4 row_mask:0xf bank_mask:0xf
    s_nop 1
    v_add_f32_dpp v38, v38, v38 row_ror:2 row_mask:0xf bank_mask:0xf
    s_nop 1
    v_add_f32_dpp v38, v38, v38 row_ror:1 row_mask:0xf bank_mask:0xf
    v_mov_b32 v40, v38
    s_nop 1
    v_permlane32_swap_b32 v38, v40
    v_add_f32 v38, v38, v40
    v_mov_b32 v40, v38
    s_nop 1
    v_permlane16_swap_b32 v38, v40
    v_add_f32 v38, v38, v40

    v_mul_f32 v38, 0x3b000000, v38
    v_sub_f32 v40, v30, v38
    v_mul_f32 v39, v40, v40
    v_sub_f32 v40, v31, v38
    v_fmac_f32 v39, v40, v40
    v_sub_f32 v40, v32, v38
    v_fmac_f32 v39, v40, v40
    v_sub_f32 v40, v33, v38
    v_fmac_f32 v39, v40, v40
    v_sub_f32 v40, v34, v38
    v_fmac_f32 v39, v40, v40
    v_sub_f32 v40, v35, v38
    v_fmac_f32 v39, v40, v40
    v_sub_f32 v40, v36, v38
    v_fmac_f32 v39, v40, v40
    v_sub_f32 v40, v37, v38
    v_fmac_f32 v39, v40, v40
    s_nop 1
    v_add_f32_dpp v39, v39, v39 row_ror:8 row_mask:0xf bank_mask:0xf
    s_nop 1
    v_add_f32_dpp v39, v39, v39 row_ror:4 row_mask:0xf bank_mask:0xf
    s_nop 1
    v_add_f32_dpp v39, v39, v39 row_ror:2 row_mask:0xf bank_mask:0xf
    s_nop 1
    v_add_f32_dpp v39, v39, v39 row_ror:1 row_mask:0xf bank_mask:0xf
    v_mov_b32 v40, v39
    s_nop 1
    v_permlane32_swap_b32 v39, v40
    v_add_f32 v39, v39, v40
    v_mov_b32 v40, v39
    s_nop 1
    v_permlane16_swap_b32 v39, v40
    v_add_f32 v39, v39, v40

    v_mul_f32 v39, 0x3b000000, v39
    v_cvt_pk_bf16_f32 v38, v38, v38
    v_and_b32 v38, 0xffff0000, v38
    v_cvt_pk_bf16_f32 v39, v39, v39
    v_and_b32 v39, 0xffff0000, v39
    v_add_f32 v39, 0x3727c5ac, v39
    v_cvt_pk_bf16_f32 v39, v39, v39
    v_and_b32 v39, 0xffff0000, v39
    v_sqrt_f32 v39, v39
    s_nop 0
    v_cvt_pk_bf16_f32 v39, v39, v39
    v_and_b32 v39, 0xffff0000, v39
    v_rcp_f32 v39, v39
    v_sub_f32 v30, v30, v38
    v_sub_f32 v31, v31, v38
    v_sub_f32 v32, v32, v38
    v_sub_f32 v33, v33, v38
    v_sub_f32 v34, v34, v38
    v_sub_f32 v35, v35, v38
    v_sub_f32 v36, v36, v38
    v_sub_f32 v37, v37, v38
    v_cvt_pk_bf16_f32 v40, v30, v31
    v_lshlrev_b32 v30, 16, v40
    v_and_b32 v31, 0xffff0000, v40
    v_mul_f32 v30, v30, v39
    v_mul_f32 v31, v31, v39
    v_cvt_pk_bf16_f32 v24, v30, v31

    v_cvt_pk_bf16_f32 v40, v32, v33
    v_lshlrev_b32 v32, 16, v40
    v_and_b32 v33, 0xffff0000, v40
    v_mul_f32 v32, v32, v39
    v_mul_f32 v33, v33, v39
    v_cvt_pk_bf16_f32 v25, v32, v33

    v_cvt_pk_bf16_f32 v40, v34, v35
    v_lshlrev_b32 v34, 16, v40
    v_and_b32 v35, 0xffff0000, v40
    v_mul_f32 v34, v34, v39
    v_mul_f32 v35, v35, v39
    v_cvt_pk_bf16_f32 v26, v34, v35

    v_cvt_pk_bf16_f32 v40, v36, v37
    v_lshlrev_b32 v36, 16, v40
    v_and_b32 v37, 0xffff0000, v40
    v_mul_f32 v36, v36, v39
    v_mul_f32 v37, v37, v39
    v_cvt_pk_bf16_f32 v27, v36, v37

    ds_write_b128 v14, v[24:27]
    v_mov_b32 v21, 163588
    s_mov_b64 exec, 1
    ds_add_u32 v21, v19
    s_mov_b64 exec, -1
L_noln_9:
    v_bfe_u32 v30, v8, 2, 2
    v_lshl_add_u32 v14, v9, 3, v30
    v_lshrrev_b32 v15, 1, v30
    v_and_b32 v16, 1, v9
    v_lshl_or_b32 v15, v16, 1, v15
    v_lshlrev_b32 v15, 5, v15
    v_lshl_add_u32 v15, v11, 3, v15
    v_lshl_add_u32 v31, v14, 7, v15
    v_cmp_gt_u32 s[70:71], 4, v10

    v_mul_u32_u24 v32, 1088, v11
    v_lshl_add_u32 v32, v9, 4, v32
    v_lshlrev_b32 v33, 6, v10
    v_lshl_add_u32 v33, v9, 4, v33
    v_lshlrev_b32 v34, 6, v11
    v_lshl_add_u32 v34, v9, 4, v34
    s_waitcnt lgkmcnt(0)
    s_add_u32 s48, s48, 0x01010101
    s_and_b32 s49, s48, 0xff
    s_bfe_u32 s50, s48, 0x80008
    s_bfe_u32 s51, s48, 0x80010
    s_lshr_b32 s52, s48, 24
    s_or_b32 s49, s49, 0x100
    s_or_b32 s50, s50, 0x200
    s_or_b32 s51, s51, 0x300

    s_cmp_eq_u32 s65, 8
    s_cbranch_scc1 L_helper
    s_cmp_eq_u32 s65, 9
    s_cbranch_scc1 L_stat

    s_mul_i32 s57, s67, 66176
    s_lshl_b32 s60, s66, 10
    s_add_u32 s57, s57, s60
    s_add_u32 s57, s57, 65536
    s_bfe_u32 s58, s2, 0x10000
    s_mul_i32 s58, s58, 117248
    s_mul_i32 s60, s63, 29312
    s_add_u32 s58, s58, s60
    s_lshl_b32 s60, s64, 10
    s_add_u32 s58, s58, s60
    s_add_u32 s58, s58, 393216
    s_cmp_ge_u32 s65, 4
    s_cselect_b32 s57, s58, s57
    s_cselect_b32 s55, s63, s67
    s_cselect_b32 s58, 8, 4
    s_mov_b32 s56, 114688
    s_cselect_b32 s56, s56, 131072
    s_lshl_b32 s55, s55, 8
    s_add_u32 s55, s55, 155648
    v_add_u32 v77, s55, v32
    s_and_b32 s55, s65, 3
    s_lshl_b32 s60, s55, 8
    s_add_u32 s57, s57, s60
    s_lshl_b32 s55, s55, 5
    v_xor_b32 v31, s55, v31
    v_add_u32 v76, s56, v31

    v_mov_b32 v21, 163588
    s_mov_b32 s59, 400000
L_w_13:
    ds_read_b32 v22, v21
    s_sub_u32 s59, s59, 1
    s_waitcnt lgkmcnt(0)
    v_readfirstlane_b32 s56, v22
    s_cselect_b32 s56, 64, s56
    s_cmp_lt_i32 s56, 4
    s_cbranch_scc1 L_w_13

    ds_read_b128 v[52:55], v77 offset:0
    ds_read_b128 v[56:59], v77 offset:64
    ds_read_b128 v[60:63], v77 offset:128
    ds_read_b128 v[64:67], v77 offset:192
    s_cmp_ge_i32 s69, s58
    s_cbranch_scc1 L_ws_16
    v_mov_b32 v21, 163584
    s_mov_b32 s59, 400000
L_w_15:
    ds_read_b32 v22, v21
    s_sub_u32 s59, s59, 1
    s_waitcnt lgkmcnt(0)
    v_readfirstlane_b32 s69, v22
    s_cselect_b32 s69, 64, s69
    s_cmp_lt_i32 s69, s58
    s_cbranch_scc1 L_w_15

L_ws_16:
    ds_read_b64_tr_b16 v[36:37], v76 offset:0
    ds_read_b64_tr_b16 v[38:39], v76 offset:512
    ds_read_b64_tr_b16 v[40:41], v76 offset:4096
    ds_read_b64_tr_b16 v[42:43], v76 offset:4608
    ds_read_b64_tr_b16 v[44:45], v76 offset:8192
    ds_read_b64_tr_b16 v[46:47], v76 offset:8704
    ds_read_b64_tr_b16 v[48:49], v76 offset:12288
    ds_read_b64_tr_b16 v[50:51], v76 offset:12800
    v_mov_b32 v21, 163592
    s_mov_b64 exec, 1
    ds_add_u32 v21, v19
    s_mov_b64 exec, -1
    s_waitcnt lgkmcnt(0)
    v_mfma_f32_16x16x32_bf16 v[68:71], v[36:39], v[52:55], 0
    v_mfma_f32_16x16x32_bf16 v[68:71], v[40:43], v[56:59], v[68:71]
    v_mfma_f32_16x16x32_bf16 v[68:71], v[44:47], v[60:63], v[68:71]
    v_mfma_f32_16x16x32_bf16 v[68:71], v[48:51], v[64:67], v[68:71]
    s_lshr_b32 s55, s65, 2
    s_mul_i32 s55, s55, s2
    s_nop 5
    v_and_or_b32 v68, v68, v20, s49
    v_and_or_b32 v69, v69, v20, s50
    v_and_or_b32 v70, v70, v20, s51
    v_and_or_b32 v71, v71, v20, s52
    s_cmp_ge_u32 s55, 224
    s_cbranch_scc1 L_qdone_12
    s_mov_b64 exec, s[70:71]
    s_add_u32 s60, s57, 2097152
    buffer_store_dwordx4 v[68:71], v33, s[28:31], s57 offen offset:0
    buffer_store_dwordx4 v[68:71], v33, s[28:31], s60 offen offset:0 sc1
    s_mov_b64 exec, -1
L_qdone_12:
    s_bfe_u32 s57, s61, 0x30000
    s_lshl_b32 s57, s57, 13
    s_lshl_b32 s60, s65, 10
    s_add_u32 s57, s57, s60
    s_bfe_u32 s60, s61, 0x20003
    s_lshl_b32 s60, s60, 6
    s_add_u32 s57, s57, s60
    s_add_u32 s57, s57, 65536
    v_mul_u32_u24 v109, 66176, v9
    v_lshl_add_u32 v109, v30, 8, v109
    v_lshl_add_u32 v109, v11, 4, v109
    s_bfe_u32 s55, s65, 0x20001
    s_mul_i32 s55, s55, 320
    s_bfe_u32 s60, s65, 0x10000
    s_lshl_b32 s60, s60, 7
    s_add_u32 s55, s55, s60
    s_add_u32 s55, s55, 160000
    v_lshlrev_b32 v110, 3, v10
    v_lshl_add_u32 v110, v9, 1, v110
    v_add_u32 v110, s55, v110
    v_xor_b32 v14, v9, v10
    v_lshlrev_b32 v14, 4, v14
    v_lshl_add_u32 v14, v10, 8, v14
    s_lshl_b32 s55, s65, 13
    v_add_u32 v104, s55, v14
    v_xor_b32 v105, 64, v104
    v_xor_b32 v106, 128, v104
    v_xor_b32 v107, 192, v104
    s_lshl_b32 s58, s65, 1
    s_add_u32 s58, s58, 10

    v_mul_u32_u24 v108, 320, v11
    v_lshl_add_u32 v108, v9, 4, v108
    v_add_u32 v108, 160000, v108
    v_lshl_add_u32 v14, v9, 2, v30
    v_and_b32 v15, 7, v14
    v_xor_b32 v15, s65, v15
    v_lshlrev_b32 v15, 5, v15
    v_lshl_add_u32 v15, v11, 3, v15
    v_lshl_add_u32 v111, v14, 8, v15
    v_add_u32 v111, 65536, v111

    s_mul_i32 s40, s61, 17408
    s_mul_i32 s60, s62, 2176
    s_add_u32 s40, s40, s60
    s_lshl_b32 s60, s65, 6
    s_add_u32 s40, s40, s60
    s_add_u32 s40, s40, 720896
    v_lshlrev_b32 v130, 9, v10
    v_lshl_add_u32 v130, v9, 4, v130
    s_bfe_u32 s41, s65, 0x20001
    s_mul_i32 s41, s41, 139264
    s_mul_i32 s60, s68, 17408
    s_add_u32 s41, s41, s60
    s_bfe_u32 s60, s64, 0x20000
    s_lshl_b32 s60, s60, 9
    s_add_u32 s41, s41, s60
    s_bfe_u32 s60, s65, 0x10000
    s_lshl_b32 s60, s60, 8
    s_add_u32 s41, s41, s60
    s_add_u32 s41, s41, 720896
    v_mul_u32_u24 v124, 2176, v9
    v_lshl_add_u32 v124, v10, 4, v124
    v_add_u32 v134, 8704, v124
    s_bfe_u32 s55, s65, 0x20001
    s_lshl_b32 s55, s55, 7
    s_bfe_u32 s60, s64, 0x20000
    s_lshl_b32 s60, s60, 2
    s_add_u32 s55, s55, s60
    s_add_u32 s55, s55, 163072
    v_lshlrev_b32 v126, 4, v9
    v_add_u32 v126, s55, v126
    s_bfe_u32 s55, s65, 0x10000
    s_lshl_b32 s55, s55, 9
    s_bfe_u32 s60, s65, 0x20001
    s_lshl_b32 s60, s60, 6
    s_add_u32 s55, s55, s60
    s_add_u32 s55, s55, 162048
    v_bfe_u32 v14, v8, 3, 1
    v_lshlrev_b32 v127, 8, v14
    v_lshl_add_u32 v127, v12, 3, v127
    v_lshl_add_u32 v127, v9, 1, v127
    v_add_u32 v127, s55, v127
    v_add_u32 v128, 131072, v31
    v_lshlrev_b32 v129, 4, v8
    s_bfe_u32 s42, s64, 0x30002
    s_mul_i32 s42, s42, 36864
    s_mul_i32 s60, s68, 4608
    s_add_u32 s42, s42, s60
    s_bfe_u32 s60, s64, 0x20000
    s_mul_i32 s60, s60, 1152
    s_add_u32 s42, s42, s60
    s_lshl_b32 s60, s65, 8
    s_add_u32 s42, s42, s60
    s_add_u32 s42, s42, 1310720
    s_cmp_ge_i32 s69, 14
    s_cbranch_scc1 L_ws_18
    v_mov_b32 v21, 163584
    s_mov_b32 s59, 400000
L_w_17:
    ds_read_b32 v22, v21
    s_sub_u32 s59, s59, 1
    s_waitcnt lgkmcnt(0)
    v_readfirstlane_b32 s69, v22
    s_cselect_b32 s69, 64, s69
    s_cmp_lt_i32 s69, 14
    s_cbranch_scc1 L_w_17

L_ws_18:
    s_mov_b32 s59, 400007
L_poll_19:
    s_and_b32 s60, s59, 7
    s_cselect_b32 s60, 0, 2097152
    s_add_u32 s60, s60, s57
    buffer_load_dwordx4 v[100:103], v109, s[28:31], s60 offen offset:0 sc1
L_pchk_20:
    s_waitcnt vmcnt(0)
    v_xor_b32 v14, s49, v100
    v_xor_b32 v15, s50, v101
    v_or_b32 v16, v14, v15
    v_xor_b32 v14, s51, v102
    v_xor_b32 v15, s52, v103
    v_or3_b32 v16, v14, v15, v16
    v_and_b32 v16, 0x3ff, v16
    v_cmp_ne_u32 vcc, 0, v16
    s_sub_u32 s59, s59, 1
    s_cbranch_scc1 L_pdone_21
    s_and_b64 exec, exec, vcc
    s_cbranch_scc1 L_poll_19
L_pdone_21:
    s_mov_b64 exec, -1
    v_and_or_b32 v100, v100, v20, s53
    v_and_or_b32 v101, v101, v20, s53
    v_and_or_b32 v102, v102, v20, s53
    v_and_or_b32 v103, v103, v20, s53
    s_nop 1
    v_permlane32_swap_b32 v100, v102
    v_permlane32_swap_b32 v101, v103
    v_add_f32 v100, v100, v102
    v_add_f32 v101, v101, v103
    s_nop 1
    v_permlane16_swap_b32 v100, v101
    v_add_f32 v100, v100, v101

    v_cvt_pk_bf16_f32 v100, v100, v100
    ds_write_b16 v110, v100
    v_mov_b32 v21, 163596
    s_mov_b64 exec, 1
    ds_add_u32 v21, v19
    s_mov_b64 exec, -1
    s_cmp_ge_i32 s69, s58
    s_cbranch_scc1 L_ws_23
    v_mov_b32 v21, 163584
    s_mov_b32 s59, 400000
L_w_22:
    ds_read_b32 v22, v21
    s_sub_u32 s59, s59, 1
    s_waitcnt lgkmcnt(0)
    v_readfirstlane_b32 s69, v22
    s_cselect_b32 s69, 64, s69
    s_cmp_lt_i32 s69, s58
    s_cbranch_scc1 L_w_22

L_ws_23:
    ds_read_b128 v[36:39], v104 offset:0
    ds_read_b128 v[40:43], v105 offset:0
    ds_read_b128 v[44:47], v106 offset:0
    ds_read_b128 v[48:51], v107 offset:0
    ds_read_b128 v[52:55], v104 offset:4096
    ds_read_b128 v[56:59], v105 offset:4096
    ds_read_b128 v[60:63], v106 offset:4096
    ds_read_b128 v[64:67], v107 offset:4096
    v_mov_b32 v21, 163596
    s_mov_b32 s59, 400000
L_w_24:
    ds_read_b32 v22, v21
    s_sub_u32 s59, s59, 1
    s_waitcnt lgkmcnt(0)
    v_readfirstlane_b32 s56, v22
    s_cselect_b32 s56, 64, s56
    s_cmp_lt_i32 s56, 8
    s_cbranch_scc1 L_w_24

    ds_read_b128 v[68:71], v108 offset:0
    ds_read_b128 v[72:75], v108 offset:64
    ds_read_b128 v[76:79], v108 offset:128
    ds_read_b128 v[80:83], v108 offset:192
    v_lshlrev_b32 v135, 5, v11
    v_add_u32 v135, 161280, v135
    s_lshl_b32 s55, s65, 2
    v_add_u32 v136, s55, v135
    s_waitcnt lgkmcnt(0)
    v_mfma_f32_16x16x32_bf16 v[84:87], v[36:39], v[68:71], 0
    v_mfma_f32_16x16x32_bf16 v[88:91], v[52:55], v[68:71], 0
    v_mfma_f32_16x16x32_bf16 v[84:87], v[40:43], v[72:75], v[84:87]
    v_mfma_f32_16x16x32_bf16 v[88:91], v[56:59], v[72:75], v[88:91]
    v_mfma_f32_16x16x32_bf16 v[84:87], v[44:47], v[76:79], v[84:87]
    v_mfma_f32_16x16x32_bf16 v[88:91], v[60:63], v[76:79], v[88:91]
    v_mfma_f32_16x16x32_bf16 v[84:87], v[48:51], v[80:83], v[84:87]
    v_mfma_f32_16x16x32_bf16 v[88:91], v[64:67], v[80:83], v[88:91]
    s_mov_b32 s55, 0x3db504f3
    s_nop 7
    v_cvt_pk_bf16_f32 v14, v84, v85
    v_lshlrev_b32 v84, 16, v14
    v_and_b32 v85, 0xffff0000, v14
    v_mul_f32 v84, s55, v84
    v_mul_f32 v85, s55, v85
    v_cvt_pk_bf16_f32 v14, v84, v85
    v_lshlrev_b32 v84, 16, v14
    v_and_b32 v85, 0xffff0000, v14

    v_cvt_pk_bf16_f32 v14, v86, v87
    v_lshlrev_b32 v86, 16, v14
    v_and_b32 v87, 0xffff0000, v14
    v_mul_f32 v86, s55, v86
    v_mul_f32 v87, s55, v87
    v_cvt_pk_bf16_f32 v14, v86, v87
    v_lshlrev_b32 v86, 16, v14
    v_and_b32 v87, 0xffff0000, v14

    v_cvt_pk_bf16_f32 v14, v88, v89
    v_lshlrev_b32 v88, 16, v14
    v_and_b32 v89, 0xffff0000, v14
    v_mul_f32 v88, s55, v88
    v_mul_f32 v89, s55, v89
    v_cvt_pk_bf16_f32 v14, v88, v89
    v_lshlrev_b32 v88, 16, v14
    v_and_b32 v89, 0xffff0000, v14

    v_cvt_pk_bf16_f32 v14, v90, v91
    v_lshlrev_b32 v90, 16, v14
    v_and_b32 v91, 0xffff0000, v14
    v_mul_f32 v90, s55, v90
    v_mul_f32 v91, s55, v91
    v_cvt_pk_bf16_f32 v14, v90, v91
    v_lshlrev_b32 v90, 16, v14
    v_and_b32 v91, 0xffff0000, v14

    v_max3_f32 v16, v84, v85, v86
    v_max3_f32 v16, v16, v87, v88
    v_max3_f32 v16, v16, v89, v90
    v_max_f32 v16, v16, v91

    v_mov_b32 v17, v16
    s_nop 1
    v_permlane32_swap_b32 v16, v17
    v_max_f32 v16, v16, v17
    v_mov_b32 v17, v16
    s_nop 1
    v_permlane16_swap_b32 v16, v17
    v_max_f32 v16, v16, v17

    ds_write_b32 v136, v16
    v_mov_b32 v21, 163600
    s_mov_b64 exec, 1
    ds_add_u32 v21, v19
    s_mov_b64 exec, -1
    v_lshlrev_b32 v138, 6, v9
    v_lshl_add_u32 v138, v11, 4, v138
    v_add_u32 v138, 155648, v138
    v_mov_b32 v21, 163600
    s_mov_b32 s59, 400000
L_w_26:
    ds_read_b32 v22, v21
    s_sub_u32 s59, s59, 1
    s_waitcnt lgkmcnt(0)
    v_readfirstlane_b32 s56, v22
    s_cselect_b32 s56, 64, s56
    s_cmp_lt_i32 s56, 8
    s_cbranch_scc1 L_w_26

    ds_read_b128 v[92:95], v135
    ds_read_b128 v[96:99], v135 offset:16
    s_mov_b32 s56, 0x3fb8aa3b
    s_lshl_b32 s55, s65, 8
    v_add_u32 v15, s55, v138
    s_waitcnt lgkmcnt(0)
    v_max3_f32 v137, v92, v93, v94
    v_max3_f32 v137, v137, v95, v96
    v_max3_f32 v137, v137, v97, v98
    v_max_f32 v137, v137, v99

    v_sub_f32 v84, v84, v137
    v_mul_f32 v84, s56, v84
    v_sub_f32 v85, v85, v137
    v_mul_f32 v85, s56, v85
    v_sub_f32 v86, v86, v137
    v_mul_f32 v86, s56, v86
    v_sub_f32 v87, v87, v137
    v_mul_f32 v87, s56, v87
    v_sub_f32 v88, v88, v137
    v_mul_f32 v88, s56, v88
    v_sub_f32 v89, v89, v137
    v_mul_f32 v89, s56, v89
    v_sub_f32 v90, v90, v137
    v_mul_f32 v90, s56, v90
    v_sub_f32 v91, v91, v137
    v_mul_f32 v91, s56, v91
    v_exp_f32 v84, v84
    v_exp_f32 v85, v85
    v_exp_f32 v86, v86
    v_exp_f32 v87, v87
    v_exp_f32 v88, v88
    v_exp_f32 v89, v89
    v_exp_f32 v90, v90
    v_exp_f32 v91, v91
    s_nop 0
    v_cvt_pk_bf16_f32 v100, v84, v85
    v_cvt_pk_bf16_f32 v101, v86, v87
    v_cvt_pk_bf16_f32 v102, v88, v89
    v_cvt_pk_bf16_f32 v103, v90, v91
    ds_write_b128 v15, v[100:103]
    v_add_f32 v16, v84, v85
    v_add_f32 v16, v16, v86
    v_add_f32 v16, v16, v87
    v_add_f32 v16, v16, v88
    v_add_f32 v16, v16, v89
    v_add_f32 v16, v16, v90
    v_add_f32 v16, v16, v91
    v_mov_b32 v17, v16
    s_nop 1
    v_permlane32_swap_b32 v16, v17
    v_add_f32 v16, v16, v17
    v_mov_b32 v17, v16
    s_nop 1
    v_permlane16_swap_b32 v16, v17
    v_add_f32 v16, v16, v17

    ds_write_b32 v136, v16 offset:128
    v_mov_b32 v21, 163604
    s_mov_b64 exec, 1
    ds_add_u32 v21, v19
    s_mov_b64 exec, -1
    v_mov_b32 v21, 163604
    s_mov_b32 s59, 400000
L_w_28:
    ds_read_b32 v22, v21
    s_sub_u32 s59, s59, 1
    s_waitcnt lgkmcnt(0)
    v_readfirstlane_b32 s56, v22
    s_cselect_b32 s56, 64, s56
    s_cmp_lt_i32 s56, 8
    s_cbranch_scc1 L_w_28

    ds_read_b128 v[36:39], v138 offset:0
    ds_read_b128 v[40:43], v138 offset:256
    ds_read_b128 v[44:47], v138 offset:512
    ds_read_b128 v[48:51], v138 offset:768
    ds_read_b128 v[52:55], v138 offset:1024
    ds_read_b128 v[56:59], v138 offset:1280
    ds_read_b128 v[60:63], v138 offset:1536
    ds_read_b128 v[64:67], v138 offset:1792
    s_cmp_ge_i32 s69, 26
    s_cbranch_scc1 L_ws_31
    v_mov_b32 v21, 163584
    s_mov_b32 s59, 400000
L_w_30:
    ds_read_b32 v22, v21
    s_sub_u32 s59, s59, 1
    s_waitcnt lgkmcnt(0)
    v_readfirstlane_b32 s69, v22
    s_cselect_b32 s69, 64, s69
    s_cmp_lt_i32 s69, 26
    s_cbranch_scc1 L_w_30

L_ws_31:
    ds_read_b64_tr_b16 v[112:113], v111 offset:0
    ds_read_b64_tr_b16 v[114:115], v111 offset:4096
    s_cmp_ge_i32 s69, 28
    s_cbranch_scc1 L_ws_33
    v_mov_b32 v21, 163584
    s_mov_b32 s59, 400000
L_w_32:
    ds_read_b32 v22, v21
    s_sub_u32 s59, s59, 1
    s_waitcnt lgkmcnt(0)
    v_readfirstlane_b32 s69, v22
    s_cselect_b32 s69, 64, s69
    s_cmp_lt_i32 s69, 28
    s_cbranch_scc1 L_w_32

L_ws_33:
    ds_read_b64_tr_b16 v[116:117], v111 offset:8192
    ds_read_b64_tr_b16 v[118:119], v111 offset:12288
    s_waitcnt lgkmcnt(2)
    v_mfma_f32_16x16x32_bf16 v[120:123], v[112:115], v[36:39], 0
    s_cmp_ge_i32 s69, 30
    s_cbranch_scc1 L_ws_35
    v_mov_b32 v21, 163584
    s_mov_b32 s59, 400000
L_w_34:
    ds_read_b32 v22, v21
    s_sub_u32 s59, s59, 1
    s_waitcnt lgkmcnt(0)
    v_readfirstlane_b32 s69, v22
    s_cselect_b32 s69, 64, s69
    s_cmp_lt_i32 s69, 30
    s_cbranch_scc1 L_w_34

L_ws_35:
    ds_read_b64_tr_b16 v[112:113], v111 offset:16384
    ds_read_b64_tr_b16 v[114:115], v111 offset:20480
    s_waitcnt lgkmcnt(2)
    v_mfma_f32_16x16x32_bf16 v[120:123], v[116:119], v[40:43], v[120:123]
    s_cmp_ge_i32 s69, 32
    s_cbranch_scc1 L_ws_37
    v_mov_b32 v21, 163584
    s_mov_b32 s59, 400000
L_w_36:
    ds_read_b32 v22, v21
    s_sub_u32 s59, s59, 1
    s_waitcnt lgkmcnt(0)
    v_readfirstlane_b32 s69, v22
    s_cselect_b32 s69, 64, s69
    s_cmp_lt_i32 s69, 32
    s_cbranch_scc1 L_w_36

L_ws_37:
    ds_read_b64_tr_b16 v[116:117], v111 offset:24576
    ds_read_b64_tr_b16 v[118:119], v111 offset:28672
    s_waitcnt lgkmcnt(2)
    v_mfma_f32_16x16x32_bf16 v[120:123], v[112:115], v[44:47], v[120:123]
    s_cmp_ge_i32 s69, 34
    s_cbranch_scc1 L_ws_39
    v_mov_b32 v21, 163584
    s_mov_b32 s59, 400000
L_w_38:
    ds_read_b32 v22, v21
    s_sub_u32 s59, s59, 1
    s_waitcnt lgkmcnt(0)
    v_readfirstlane_b32 s69, v22
    s_cselect_b32 s69, 64, s69
    s_cmp_lt_i32 s69, 34
    s_cbranch_scc1 L_w_38

L_ws_39:
    ds_read_b64_tr_b16 v[112:113], v111 offset:32768
    ds_read_b64_tr_b16 v[114:115], v111 offset:36864
    s_waitcnt lgkmcnt(2)
    v_mfma_f32_16x16x32_bf16 v[120:123], v[116:119], v[48:51], v[120:123]
    s_cmp_ge_i32 s69, 36
    s_cbranch_scc1 L_ws_41
    v_mov_b32 v21, 163584
    s_mov_b32 s59, 400000
L_w_40:
    ds_read_b32 v22, v21
    s_sub_u32 s59, s59, 1
    s_waitcnt lgkmcnt(0)
    v_readfirstlane_b32 s69, v22
    s_cselect_b32 s69, 64, s69
    s_cmp_lt_i32 s69, 36
    s_cbranch_scc1 L_w_40

L_ws_41:
    ds_read_b64_tr_b16 v[116:117], v111 offset:40960
    ds_read_b64_tr_b16 v[118:119], v111 offset:45056
    s_waitcnt lgkmcnt(2)
    v_mfma_f32_16x16x32_bf16 v[120:123], v[112:115], v[52:55], v[120:123]
    s_cmp_ge_i32 s69, 38
    s_cbranch_scc1 L_ws_43
    v_mov_b32 v21, 163584
    s_mov_b32 s59, 400000
L_w_42:
    ds_read_b32 v22, v21
    s_sub_u32 s59, s59, 1
    s_waitcnt lgkmcnt(0)
    v_readfirstlane_b32 s69, v22
    s_cselect_b32 s69, 64, s69
    s_cmp_lt_i32 s69, 38
    s_cbranch_scc1 L_w_42

L_ws_43:
    ds_read_b64_tr_b16 v[112:113], v111 offset:49152
    ds_read_b64_tr_b16 v[114:115], v111 offset:53248
    s_waitcnt lgkmcnt(2)
    v_mfma_f32_16x16x32_bf16 v[120:123], v[116:119], v[56:59], v[120:123]
    s_cmp_ge_i32 s69, 40
    s_cbranch_scc1 L_ws_45
    v_mov_b32 v21, 163584
    s_mov_b32 s59, 400000
L_w_44:
    ds_read_b32 v22, v21
    s_sub_u32 s59, s59, 1
    s_waitcnt lgkmcnt(0)
    v_readfirstlane_b32 s69, v22
    s_cselect_b32 s69, 64, s69
    s_cmp_lt_i32 s69, 40
    s_cbranch_scc1 L_w_44

L_ws_45:
    ds_read_b64_tr_b16 v[116:117], v111 offset:57344
    ds_read_b64_tr_b16 v[118:119], v111 offset:61440
    s_waitcnt lgkmcnt(2)
    v_mfma_f32_16x16x32_bf16 v[120:123], v[112:115], v[60:63], v[120:123]
    s_waitcnt lgkmcnt(0)
    v_mfma_f32_16x16x32_bf16 v[120:123], v[116:119], v[64:67], v[120:123]
    s_nop 7
    v_and_or_b32 v120, v120, v20, s49
    v_and_or_b32 v121, v121, v20, s50
    v_and_or_b32 v122, v122, v20, s51
    v_and_or_b32 v123, v123, v20, s52
    s_mov_b64 exec, s[70:71]
    buffer_store_dwordx4 v[120:123], v130, s[28:31], s40 offen offset:0
    s_mov_b64 exec, -1
    v_add_u32 v17, 162048, v34
    s_cmp_ge_i32 s69, 45
    s_cbranch_scc1 L_ws_47
    v_mov_b32 v21, 163584
    s_mov_b32 s59, 400000
L_w_46:
    ds_read_b32 v22, v21
    s_sub_u32 s59, s59, 1
    s_waitcnt lgkmcnt(0)
    v_readfirstlane_b32 s69, v22
    s_cselect_b32 s69, 64, s69
    s_cmp_lt_i32 s69, 45
    s_cbranch_scc1 L_w_46

L_ws_47:
    buffer_load_dwordx4 v[36:39], v124, s[28:31], s41 offen offset:0 sc1
    buffer_load_dwordx4 v[40:43], v134, s[28:31], s41 offen offset:0 sc1
    s_cmp_ge_i32 s69, 46
    s_cbranch_scc1 L_ws_49
    v_mov_b32 v21, 163584
    s_mov_b32 s59, 400000
L_w_48:
    ds_read_b32 v22, v21
    s_sub_u32 s59, s59, 1
    s_waitcnt lgkmcnt(0)
    v_readfirstlane_b32 s69, v22
    s_cselect_b32 s69, 64, s69
    s_cmp_lt_i32 s69, 46
    s_cbranch_scc1 L_w_48

L_ws_49:
    ds_read_b64_tr_b16 v[68:69], v128 offset:0
    ds_read_b64_tr_b16 v[70:71], v128 offset:512
    ds_read_b64_tr_b16 v[72:73], v128 offset:4096
    ds_read_b64_tr_b16 v[74:75], v128 offset:4608
    ds_read_b64_tr_b16 v[76:77], v128 offset:8192
    ds_read_b64_tr_b16 v[78:79], v128 offset:8704
    ds_read_b64_tr_b16 v[80:81], v128 offset:12288
    ds_read_b64_tr_b16 v[82:83], v128 offset:12800
    s_mov_b32 s59, 400031
    s_branch L_pchk_51
L_poll_50:
    s_and_b32 s60, s59, 31
    s_cbranch_scc1 L_nlz_53
    s_mov_b64 vcc, exec
    s_mov_b64 exec, s[70:71]
    s_add_u32 s60, s40, 2097152
    buffer_store_dwordx4 v[120:123], v130, s[28:31], s60 offen offset:0 sc1
    s_mov_b64 exec, -1
    s_mov_b64 exec, vcc
L_nlz_53:
    s_and_b32 s60, s59, 31
    s_cselect_b32 s60, 0, 2097152
    s_add_u32 s60, s60, s41
    buffer_load_dwordx4 v[36:39], v124, s[28:31], s60 offen offset:0 sc1
    buffer_load_dwordx4 v[40:43], v134, s[28:31], s60 offen offset:0 sc1
L_pchk_51:
    s_waitcnt vmcnt(0)
    v_xor_b32 v14, s49, v36
    v_xor_b32 v15, s50, v37
    v_or_b32 v16, v14, v15
    v_xor_b32 v14, s51, v38
    v_xor_b32 v15, s52, v39
    v_or3_b32 v16, v14, v15, v16
    v_xor_b32 v14, s49, v40
    v_xor_b32 v15, s50, v41
    v_or3_b32 v16, v14, v15, v16
    v_xor_b32 v14, s51, v42
    v_xor_b32 v15, s52, v43
    v_or3_b32 v16, v14, v15, v16
    v_and_b32 v16, 0x3ff, v16
    v_cmp_ne_u32 vcc, 0, v16
    s_sub_u32 s59, s59, 1
    s_cbranch_scc1 L_pdone_52
    s_and_b64 exec, exec, vcc
    s_cbranch_scc1 L_poll_50
L_pdone_52:
    s_mov_b64 exec, -1
    v_and_or_b32 v36, v36, v20, s53
    v_and_or_b32 v37, v37, v20, s53
    v_and_or_b32 v38, v38, v20, s53
    v_and_or_b32 v39, v39, v20, s53
    v_and_or_b32 v40, v40, v20, s53
    v_and_or_b32 v41, v41, v20, s53
    v_and_or_b32 v42, v42, v20, s53
    v_and_or_b32 v43, v43, v20, s53
    v_mov_b32 v21, 163608
    s_mov_b32 s59, 400000
L_w_54:
    ds_read_b32 v22, v21
    s_sub_u32 s59, s59, 1
    s_waitcnt lgkmcnt(0)
    v_readfirstlane_b32 s56, v22
    s_cselect_b32 s56, 64, s56
    s_cmp_lt_i32 s56, 1
    s_cbranch_scc1 L_w_54

    ds_read2_b32 v[132:133], v126 offset0:0 offset1:16
    s_waitcnt lgkmcnt(0)
    v_mul_f32 v36, v36, v132
    v_mul_f32 v37, v37, v132
    v_mul_f32 v38, v38, v132
    v_mul_f32 v39, v39, v132
    v_fmac_f32 v36, v40, v133
    v_fmac_f32 v37, v41, v133
    v_fmac_f32 v38, v42, v133
    v_fmac_f32 v39, v43, v133
    s_nop 1
    v_permlane32_swap_b32 v36, v38
    v_permlane32_swap_b32 v37, v39
    v_add_f32 v36, v36, v38
    v_add_f32 v37, v37, v39
    s_nop 1
    v_permlane16_swap_b32 v36, v37
    v_add_f32 v36, v36, v37

    v_cvt_pk_bf16_f32 v36, v36, v36
    ds_write_b16 v127, v36
    v_mov_b32 v21, 163612
    s_mov_b64 exec, 1
    ds_add_u32 v21, v19
    s_mov_b64 exec, -1
    s_mov_b64 exec, s[70:71]
    s_add_u32 s60, s40, 2097152
    buffer_store_dwordx4 v[120:123], v130, s[28:31], s60 offen offset:0 sc1
    s_mov_b64 exec, -1
    s_cmp_ge_u32 s65, 4
    s_cbranch_scc1 L_olz_56
    v_mov_b32 v21, 163612
    s_mov_b32 s59, 400000
L_w_57:
    ds_read_b32 v22, v21
    s_sub_u32 s59, s59, 1
    s_waitcnt lgkmcnt(0)
    v_readfirstlane_b32 s56, v22
    s_cselect_b32 s56, 64, s56
    s_cmp_lt_i32 s56, 8
    s_cbranch_scc1 L_w_57

    ds_read_b128 v[44:47], v17 offset:0
    ds_read_b128 v[48:51], v17 offset:256
    ds_read_b128 v[52:55], v17 offset:512
    ds_read_b128 v[56:59], v17 offset:768
    s_waitcnt lgkmcnt(2)
    v_mfma_f32_16x16x32_bf16 v[84:87], v[44:47], v[68:71], 0
    v_mfma_f32_16x16x32_bf16 v[88:91], v[48:51], v[72:75], 0
    s_waitcnt lgkmcnt(0)
    v_mfma_f32_16x16x32_bf16 v[84:87], v[52:55], v[76:79], v[84:87]
    v_mfma_f32_16x16x32_bf16 v[88:91], v[56:59], v[80:83], v[88:91]
    s_nop 7
    v_add_f32 v84, v84, v88
    v_add_f32 v85, v85, v89
    v_add_f32 v86, v86, v90
    v_add_f32 v87, v87, v91
    v_and_or_b32 v84, v84, v20, s49
    v_and_or_b32 v85, v85, v20, s50
    v_and_or_b32 v86, v86, v20, s51
    v_and_or_b32 v87, v87, v20, s52
    s_mov_b64 exec, 0xffff
    buffer_store_dwordx4 v[84:87], v129, s[28:31], s42 offen offset:0 sc1
    s_mov_b64 exec, -1
    s_waitcnt vmcnt(0)
    v_mov_b32 v21, 163624
    s_mov_b64 exec, 1
    ds_add_u32 v21, v19
    s_mov_b64 exec, -1
L_olz_56:
    s_endpgm
L_helper:
    v_mov_b32 v21, 163592
    s_mov_b64 exec, 1
    ds_add_u32 v21, v19
    s_mov_b64 exec, -1
    s_min_u32 s55, s64, 27
    v_lshlrev_b32 v115, 4, v8
    s_lshl_b32 s40, s55, 10
    s_add_u32 s40, s40, 2490368
    s_add_u32 s41, s40, 29312
    s_add_u32 s42, s40, 58624
    s_add_u32 s43, s40, 87936
    s_add_u32 s44, s40, 117248
    s_add_u32 s45, s40, 146560
    s_add_u32 s46, s40, 175872
    s_add_u32 s47, s40, 205184
    v_lshrrev_b32 v14, 1, v9
    v_and_b32 v15, 1, v9
    v_lshlrev_b32 v113, 8, v14
    v_lshl_add_u32 v113, v30, 6, v113
    v_lshl_add_u32 v113, v15, 5, v113
    v_lshl_add_u32 v113, v11, 3, v113
    v_add_u32 v113, 161536, v113
    v_add_u32 v114, 147456, v31
    s_cmp_ge_i32 s69, 24
    s_cbranch_scc1 L_ws_60
    v_mov_b32 v21, 163584
    s_mov_b32 s59, 400000
L_w_59:
    ds_read_b32 v22, v21
    s_sub_u32 s59, s59, 1
    s_waitcnt lgkmcnt(0)
    v_readfirstlane_b32 s69, v22
    s_cselect_b32 s69, 64, s69
    s_cmp_lt_i32 s69, 24
    s_cbranch_scc1 L_w_59

L_ws_60:
    s_mov_b32 s59, 400000
L_poll_61:
    buffer_load_dwordx4 v[36:39], v115, s[28:31], s40 offen offset:0 sc1
    buffer_load_dwordx4 v[40:43], v115, s[28:31], s41 offen offset:0 sc1
    buffer_load_dwordx4 v[44:47], v115, s[28:31], s42 offen offset:0 sc1
    buffer_load_dwordx4 v[48:51], v115, s[28:31], s43 offen offset:0 sc1
    buffer_load_dwordx4 v[52:55], v115, s[28:31], s44 offen offset:0 sc1
    buffer_load_dwordx4 v[56:59], v115, s[28:31], s45 offen offset:0 sc1
    buffer_load_dwordx4 v[60:63], v115, s[28:31], s46 offen offset:0 sc1
    buffer_load_dwordx4 v[64:67], v115, s[28:31], s47 offen offset:0 sc1
    s_waitcnt vmcnt(0)
L_pchk_62:
    v_xor_b32 v14, s49, v36
    v_xor_b32 v15, s50, v37
    v_or_b32 v16, v14, v15
    v_xor_b32 v14, s51, v38
    v_xor_b32 v15, s52, v39
    v_or3_b32 v16, v14, v15, v16
    v_xor_b32 v14, s49, v40
    v_xor_b32 v15, s50, v41
    v_or3_b32 v16, v14, v15, v16
    v_xor_b32 v14, s51, v42
    v_xor_b32 v15, s52, v43
    v_or3_b32 v16, v14, v15, v16
    v_xor_b32 v14, s49, v44
    v_xor_b32 v15, s50, v45
    v_or3_b32 v16, v14, v15, v16
    v_xor_b32 v14, s51, v46
    v_xor_b32 v15, s52, v47
    v_or3_b32 v16, v14, v15, v16
    v_xor_b32 v14, s49, v48
    v_xor_b32 v15, s50, v49
    v_or3_b32 v16, v14, v15, v16
    v_xor_b32 v14, s51, v50
    v_xor_b32 v15, s52, v51
    v_or3_b32 v16, v14, v15, v16
    v_xor_b32 v14, s49, v52
    v_xor_b32 v15, s50, v53
    v_or3_b32 v16, v14, v15, v16
    v_xor_b32 v14, s51, v54
    v_xor_b32 v15, s52, v55
    v_or3_b32 v16, v14, v15, v16
    v_xor_b32 v14, s49, v56
    v_xor_b32 v15, s50, v57
    v_or3_b32 v16, v14, v15, v16
    v_xor_b32 v14, s51, v58
    v_xor_b32 v15, s52, v59
    v_or3_b32 v16, v14, v15, v16
    v_xor_b32 v14, s49, v60
    v_xor_b32 v15, s50, v61
    v_or3_b32 v16, v14, v15, v16
    v_xor_b32 v14, s51, v62
    v_xor_b32 v15, s52, v63
    v_or3_b32 v16, v14, v15, v16
    v_xor_b32 v14, s49, v64
    v_xor_b32 v15, s50, v65
    v_or3_b32 v16, v14, v15, v16
    v_xor_b32 v14, s51, v66
    v_xor_b32 v15, s52, v67
    v_or3_b32 v16, v14, v15, v16
    v_and_b32 v16, 0x3ff, v16
    v_cmp_ne_u32 vcc, 0, v16
    s_sub_u32 s59, s59, 1
    s_cbranch_scc1 L_pdone_63
    s_and_b64 exec, exec, vcc
    s_cbranch_scc1 L_poll_61
L_pdone_63:
    s_mov_b64 exec, -1
    v_and_or_b32 v36, v36, v20, s53
    v_and_or_b32 v37, v37, v20, s53
    v_and_or_b32 v38, v38, v20, s53
    v_and_or_b32 v39, v39, v20, s53
    v_and_or_b32 v40, v40, v20, s53
    v_and_or_b32 v41, v41, v20, s53
    v_and_or_b32 v42, v42, v20, s53
    v_and_or_b32 v43, v43, v20, s53
    v_and_or_b32 v44, v44, v20, s53
    v_and_or_b32 v45, v45, v20, s53
    v_and_or_b32 v46, v46, v20, s53
    v_and_or_b32 v47, v47, v20, s53
    v_and_or_b32 v48, v48, v20, s53
    v_and_or_b32 v49, v49, v20, s53
    v_and_or_b32 v50, v50, v20, s53
    v_and_or_b32 v51, v51, v20, s53
    v_and_or_b32 v52, v52, v20, s53
    v_and_or_b32 v53, v53, v20, s53
    v_and_or_b32 v54, v54, v20, s53
    v_and_or_b32 v55, v55, v20, s53
    v_and_or_b32 v56, v56, v20, s53
    v_and_or_b32 v57, v57, v20, s53
    v_and_or_b32 v58, v58, v20, s53
    v_and_or_b32 v59, v59, v20, s53
    v_and_or_b32 v60, v60, v20, s53
    v_and_or_b32 v61, v61, v20, s53
    v_and_or_b32 v62, v62, v20, s53
    v_and_or_b32 v63, v63, v20, s53
    v_and_or_b32 v64, v64, v20, s53
    v_and_or_b32 v65, v65, v20, s53
    v_and_or_b32 v66, v66, v20, s53
    v_and_or_b32 v67, v67, v20, s53
    v_add_f32 v36, v36, v40
    v_add_f32 v44, v44, v48
    v_add_f32 v37, v37, v41
    v_add_f32 v45, v45, v49
    v_add_f32 v38, v38, v42
    v_add_f32 v46, v46, v50
    v_add_f32 v39, v39, v43
    v_add_f32 v47, v47, v51
    v_add_f32 v36, v36, v44
    v_add_f32 v37, v37, v45
    v_add_f32 v38, v38, v46
    v_add_f32 v39, v39, v47
    v_cvt_pk_bf16_f32 v36, v36, v36
    v_and_b32 v36, 0xffff0000, v36
    v_cvt_pk_bf16_f32 v37, v37, v37
    v_and_b32 v37, 0xffff0000, v37
    v_cvt_pk_bf16_f32 v38, v38, v38
    v_and_b32 v38, 0xffff0000, v38
    v_cvt_pk_bf16_f32 v39, v39, v39
    v_and_b32 v39, 0xffff0000, v39
    v_add_f32 v52, v52, v56
    v_add_f32 v60, v60, v64
    v_add_f32 v53, v53, v57
    v_add_f32 v61, v61, v65
    v_add_f32 v54, v54, v58
    v_add_f32 v62, v62, v66
    v_add_f32 v55, v55, v59
    v_add_f32 v63, v63, v67
    v_add_f32 v52, v52, v60
    v_add_f32 v53, v53, v61
    v_add_f32 v54, v54, v62
    v_add_f32 v55, v55, v63
    v_cvt_pk_bf16_f32 v52, v52, v52
    v_and_b32 v52, 0xffff0000, v52
    v_cvt_pk_bf16_f32 v53, v53, v53
    v_and_b32 v53, 0xffff0000, v53
    v_cvt_pk_bf16_f32 v54, v54, v54
    v_and_b32 v54, 0xffff0000, v54
    v_cvt_pk_bf16_f32 v55, v55, v55
    v_and_b32 v55, 0xffff0000, v55
    v_mul_f32 v14, 0xbfb8aa3b, v36
    v_exp_f32 v14, v14
    s_nop 0
    v_add_f32 v14, 1.0, v14
    v_rcp_f32 v14, v14
    s_nop 0
    v_mul_f32 v36, v36, v14

    v_cvt_pk_bf16_f32 v36, v36, v36
    v_and_b32 v36, 0xffff0000, v36
    v_mul_f32 v36, v36, v52
    v_mul_f32 v14, 0xbfb8aa3b, v37
    v_exp_f32 v14, v14
    s_nop 0
    v_add_f32 v14, 1.0, v14
    v_rcp_f32 v14, v14
    s_nop 0
    v_mul_f32 v37, v37, v14

    v_cvt_pk_bf16_f32 v37, v37, v37
    v_and_b32 v37, 0xffff0000, v37
    v_mul_f32 v37, v37, v53
    v_mul_f32 v14, 0xbfb8aa3b, v38
    v_exp_f32 v14, v14
    s_nop 0
    v_add_f32 v14, 1.0, v14
    v_rcp_f32 v14, v14
    s_nop 0
    v_mul_f32 v38, v38, v14

    v_cvt_pk_bf16_f32 v38, v38, v38
    v_and_b32 v38, 0xffff0000, v38
    v_mul_f32 v38, v38, v54
    v_mul_f32 v14, 0xbfb8aa3b, v39
    v_exp_f32 v14, v14
    s_nop 0
    v_add_f32 v14, 1.0, v14
    v_rcp_f32 v14, v14
    s_nop 0
    v_mul_f32 v39, v39, v14

    v_cvt_pk_bf16_f32 v39, v39, v39
    v_and_b32 v39, 0xffff0000, v39
    v_mul_f32 v39, v39, v55
    v_cvt_pk_bf16_f32 v36, v36, v37
    v_cvt_pk_bf16_f32 v37, v38, v39
    ds_write_b64 v113, v[36:37]
    v_add_u32 v17, 161536, v34
    ds_read_b128 v[104:107], v17
    ds_read_b128 v[108:111], v17 offset:256

    s_mul_i32 s40, s68, 36864
    s_mul_i32 s60, s64, 1152
    s_add_u32 s40, s40, s60
    s_add_u32 s40, s40, 1638400
    s_mul_i32 s44, s68, 36864
    s_lshl_b32 s60, s64, 5
    s_add_u32 s44, s44, s60
    s_add_u32 s44, s44, 1638400
    v_lshrrev_b32 v14, 1, v8
    v_and_b32 v15, 1, v8
    v_min_u32 v14, 27, v14
    v_cmp_gt_u32 s[70:71], 56, v8

    v_mul_u32_u24 v112, 1152, v14
    v_lshl_add_u32 v112, v15, 4, v112
    v_lshlrev_b32 v113, 2, v8
    v_add_u32 v113, 157696, v113
    s_cmp_ge_u32 s64, 28
    s_cbranch_scc1 L_nodn_64
    s_cmp_ge_i32 s69, 42
    s_cbranch_scc1 L_ws_66
    v_mov_b32 v21, 163584
    s_mov_b32 s59, 400000
L_w_65:
    ds_read_b32 v22, v21
    s_sub_u32 s59, s59, 1
    s_waitcnt lgkmcnt(0)
    v_readfirstlane_b32 s69, v22
    s_cselect_b32 s69, 64, s69
    s_cmp_lt_i32 s69, 42
    s_cbranch_scc1 L_w_65

L_ws_66:
    v_xor_b32 v14, 0, v114
    ds_read_b64_tr_b16 v[68:69], v14 offset:0
    ds_read_b64_tr_b16 v[70:71], v14 offset:512
    ds_read_b64_tr_b16 v[72:73], v14 offset:4096
    ds_read_b64_tr_b16 v[74:75], v14 offset:4608
    v_xor_b32 v14, 32, v114
    ds_read_b64_tr_b16 v[76:77], v14 offset:0
    ds_read_b64_tr_b16 v[78:79], v14 offset:512
    ds_read_b64_tr_b16 v[80:81], v14 offset:4096
    ds_read_b64_tr_b16 v[82:83], v14 offset:4608
    v_xor_b32 v14, 64, v114
    ds_read_b64_tr_b16 v[84:85], v14 offset:0
    ds_read_b64_tr_b16 v[86:87], v14 offset:512
    ds_read_b64_tr_b16 v[88:89], v14 offset:4096
    ds_read_b64_tr_b16 v[90:91], v14 offset:4608
    v_xor_b32 v14, 96, v114
    ds_read_b64_tr_b16 v[92:93], v14 offset:0
    ds_read_b64_tr_b16 v[94:95], v14 offset:512
    ds_read_b64_tr_b16 v[96:97], v14 offset:4096
    ds_read_b64_tr_b16 v[98:99], v14 offset:4608
    s_waitcnt lgkmcnt(0)
    v_mfma_f32_16x16x32_bf16 v[36:39], v[104:107], v[68:71], 0
    v_mfma_f32_16x16x32_bf16 v[40:43], v[104:107], v[76:79], 0
    v_mfma_f32_16x16x32_bf16 v[44:47], v[104:107], v[84:87], 0
    v_mfma_f32_16x16x32_bf16 v[48:51], v[104:107], v[92:95], 0
    v_mfma_f32_16x16x32_bf16 v[36:39], v[108:111], v[72:75], v[36:39]
    v_mfma_f32_16x16x32_bf16 v[40:43], v[108:111], v[80:83], v[40:43]
    v_mfma_f32_16x16x32_bf16 v[44:47], v[108:111], v[88:91], v[44:47]
    v_mfma_f32_16x16x32_bf16 v[48:51], v[108:111], v[96:99], v[48:51]
    s_nop 4
    v_and_or_b32 v36, v36, v20, s49
    v_and_or_b32 v37, v37, v20, s50
    v_and_or_b32 v38, v38, v20, s51
    v_and_or_b32 v39, v39, v20, s52
    v_and_or_b32 v40, v40, v20, s49
    v_and_or_b32 v41, v41, v20, s50
    v_and_or_b32 v42, v42, v20, s51
    v_and_or_b32 v43, v43, v20, s52
    v_and_or_b32 v44, v44, v20, s49
    v_and_or_b32 v45, v45, v20, s50
    v_and_or_b32 v46, v46, v20, s51
    v_and_or_b32 v47, v47, v20, s52
    v_and_or_b32 v48, v48, v20, s49
    v_and_or_b32 v49, v49, v20, s50
    v_and_or_b32 v50, v50, v20, s51
    v_and_or_b32 v51, v51, v20, s52
    s_mov_b64 exec, 0xffff
    buffer_store_dwordx4 v[36:39], v115, s[28:31], s40 offen offset:0
    buffer_store_dwordx4 v[40:43], v115, s[28:31], s40 offen offset:256
    buffer_store_dwordx4 v[44:47], v115, s[28:31], s40 offen offset:512
    buffer_store_dwordx4 v[48:51], v115, s[28:31], s40 offen offset:768
    s_mov_b64 exec, -1
L_nodn_64:
    s_cmp_ge_i32 s69, 44
    s_cbranch_scc1 L_ws_68
    v_mov_b32 v21, 163584
    s_mov_b32 s59, 400000
L_w_67:
    ds_read_b32 v22, v21
    s_sub_u32 s59, s59, 1
    s_waitcnt lgkmcnt(0)
    v_readfirstlane_b32 s69, v22
    s_cselect_b32 s69, 64, s69
    s_cmp_lt_i32 s69, 44
    s_cbranch_scc1 L_w_67

L_ws_68:
    s_mov_b32 s59, 400031
L_poll_69:
    s_and_b32 s60, s59, 31
    s_cbranch_scc1 L_nlz_72
    s_mov_b64 vcc, exec
    s_cmp_ge_u32 s64, 28
    s_cbranch_scc1 L_nf_73
    s_mov_b64 exec, 0xffff
    s_add_u32 s60, s40, 2097152
    buffer_store_dwordx4 v[36:39], v115, s[28:31], s60 offen offset:0 sc1
    buffer_store_dwordx4 v[40:43], v115, s[28:31], s60 offen offset:256 sc1
    buffer_store_dwordx4 v[44:47], v115, s[28:31], s60 offen offset:512 sc1
    buffer_store_dwordx4 v[48:51], v115, s[28:31], s60 offen offset:768 sc1
    s_mov_b64 exec, -1
L_nf_73:
    s_mov_b64 exec, vcc
L_nlz_72:
    s_and_b32 s60, s59, 31
    s_cselect_b32 s60, 0, 2097152
    s_add_u32 s60, s60, s44
    buffer_load_dwordx4 v[68:71], v112, s[28:31], s60 offen offset:0 sc1
L_pchk_70:
    s_waitcnt vmcnt(0)
    v_xor_b32 v14, s49, v68
    v_xor_b32 v15, s50, v69
    v_or_b32 v16, v14, v15
    v_xor_b32 v14, s51, v70
    v_xor_b32 v15, s52, v71
    v_or3_b32 v16, v14, v15, v16
    v_and_b32 v16, 0x3ff, v16
    v_cmp_ne_u32 vcc, 0, v16
    s_sub_u32 s59, s59, 1
    s_cbranch_scc1 L_pdone_71
    s_and_b64 exec, exec, vcc
    s_cbranch_scc1 L_poll_69
L_pdone_71:
    s_mov_b64 exec, -1
    v_and_or_b32 v68, v68, v20, s53
    v_and_or_b32 v69, v69, v20, s53
    v_and_or_b32 v70, v70, v20, s53
    v_and_or_b32 v71, v71, v20, s53
    v_cndmask_b32 v68, 0, v68, s[70:71]
    v_cndmask_b32 v69, 0, v69, s[70:71]
    v_cndmask_b32 v70, 0, v70, s[70:71]
    v_cndmask_b32 v71, 0, v71, s[70:71]
    s_nop 1
    v_permlane32_swap_b32 v68, v70
    v_permlane32_swap_b32 v69, v71
    v_add_f32 v68, v68, v70
    v_add_f32 v69, v69, v71
    s_nop 1
    v_permlane16_swap_b32 v68, v69
    v_add_f32 v68, v68, v69

    s_nop 1
    v_add_f32_dpp v68, v68, v68 row_ror:8 row_mask:0xf bank_mask:0xf
    s_nop 1
    v_add_f32_dpp v68, v68, v68 row_ror:4 row_mask:0xf bank_mask:0xf
    s_nop 1
    v_add_f32_dpp v68, v68, v68 row_ror:2 row_mask:0xf bank_mask:0xf
    v_cvt_pk_bf16_f32 v68, v68, v68
    v_and_b32 v68, 0xffff0000, v68
    v_mul_f32 v14, 0xbfb8aa3b, v68
    v_exp_f32 v14, v14
    s_nop 0
    v_add_f32 v14, 1.0, v14
    v_rcp_f32 v14, v14
    s_nop 0
    v_mul_f32 v68, v68, v14

    v_cvt_pk_bf16_f32 v68, v68, v68
    v_and_b32 v68, 0xffff0000, v68
    ds_write_b32 v113, v68
    v_mov_b32 v21, 163616
    s_mov_b64 exec, 1
    ds_add_u32 v21, v19
    s_mov_b64 exec, -1
    s_cmp_ge_u32 s64, 28
    s_cbranch_scc1 L_nf_74
    s_mov_b64 exec, 0xffff
    s_add_u32 s60, s40, 2097152
    buffer_store_dwordx4 v[36:39], v115, s[28:31], s60 offen offset:0 sc1
    buffer_store_dwordx4 v[40:43], v115, s[28:31], s60 offen offset:256 sc1
    buffer_store_dwordx4 v[44:47], v115, s[28:31], s60 offen offset:512 sc1
    buffer_store_dwordx4 v[48:51], v115, s[28:31], s60 offen offset:768 sc1
    s_mov_b64 exec, -1
L_nf_74:
    s_endpgm
L_stat:
    s_cmp_ge_i32 s69, 0
    s_cbranch_scc1 L_ws_76
    v_mov_b32 v21, 163584
    s_mov_b32 s59, 400000
L_w_75:
    ds_read_b32 v22, v21
    s_sub_u32 s59, s59, 1
    s_waitcnt lgkmcnt(0)
    v_readfirstlane_b32 s69, v22
    s_cselect_b32 s69, 64, s69
    s_cmp_lt_i32 s69, 0
    s_cbranch_scc1 L_w_75

L_ws_76:
    v_add_u32 v14, 147456, v29
    ds_read_u16 v28, v14
    s_waitcnt lgkmcnt(0)
    v_mov_b32 v21, 163592
    s_mov_b64 exec, 1
    ds_add_u32 v21, v19
    s_mov_b64 exec, -1
    v_bfe_u32 v14, v8, 1, 1
    v_bfe_u32 v15, v8, 2, 1
    v_and_b32 v16, 1, v8
    v_lshlrev_b32 v84, 7, v14
    v_lshl_add_u32 v84, v15, 6, v84
    v_lshl_add_u32 v84, v16, 5, v84
    v_add_u32 v84, 161280, v84
    v_cmp_eq_u32 s[70:71], 0, v14
    v_lshlrev_b32 v85, 4, v8
    v_lshlrev_b32 v86, 3, v8
    v_add_u32 v86, 163072, v86
    v_lshlrev_b32 v87, 2, v8
    v_add_u32 v87, 157696, v87
    s_mul_i32 s58, s68, 1152
    s_add_u32 s58, s58, 655360
    v_lshrrev_b32 v14, 1, v8
    v_lshlrev_b32 v89, 5, v14
    v_lshl_add_u32 v89, v16, 4, v89
    s_bfe_u32 s57, s61, 0x30000
    s_mul_i32 s57, s57, 1152
    s_bfe_u32 s60, s61, 0x20003
    s_lshl_b32 s60, s60, 8
    s_add_u32 s57, s57, s60
    s_lshl_b32 s60, s62, 5
    s_add_u32 s57, s57, s60
    s_add_u32 s57, s57, 655360
    v_mov_b32 v21, 163604
    s_mov_b32 s59, 400000
L_w_77:
    ds_read_b32 v22, v21
    s_sub_u32 s59, s59, 1
    s_waitcnt lgkmcnt(0)
    v_readfirstlane_b32 s56, v22
    s_cselect_b32 s56, 64, s56
    s_cmp_lt_i32 s56, 8
    s_cbranch_scc1 L_w_77

    ds_read_b128 v[76:79], v84
    ds_read_b128 v[80:83], v84 offset:16
    s_waitcnt lgkmcnt(0)
    v_max3_f32 v14, v76, v77, v78
    v_max3_f32 v14, v14, v79, v80
    v_max3_f32 v14, v14, v81, v82
    v_max_f32 v14, v14, v83
    v_add_f32 v15, v76, v77

    v_add_f32 v15, v15, v78
    v_add_f32 v15, v15, v79
    v_add_f32 v15, v15, v80
    v_add_f32 v15, v15, v81
    v_add_f32 v15, v15, v82
    v_add_f32 v15, v15, v83
    v_cndmask_b32 v14, v15, v14, s[70:71]
    s_nop 1
    v_mov_b32_dpp v76, v14 quad_perm:[0,0,0,0] row_mask:0xf bank_mask:0xf
    v_mov_b32_dpp v77, v14 quad_perm:[1,1,1,1] row_mask:0xf bank_mask:0xf
    v_mov_b32_dpp v78, v14 quad_perm:[2,2,2,2] row_mask:0xf bank_mask:0xf
    v_mov_b32_dpp v79, v14 quad_perm:[3,3,3,3] row_mask:0xf bank_mask:0xf
    v_and_or_b32 v76, v76, v20, s49
    v_and_or_b32 v77, v77, v20, s50
    v_and_or_b32 v78, v78, v20, s51
    v_and_or_b32 v79, v79, v20, s52
    v_lshlrev_b32 v14, 2, v8
    v_mov_b32 v90, v14
    s_mov_b64 exec, 0x11
    buffer_store_dwordx4 v[76:79], v90, s[28:31], s57 offen offset:0
    s_mov_b64 exec, -1
    s_cmp_ge_i32 s69, 36
    s_cbranch_scc1 L_ws_80
    v_mov_b32 v21, 163584
    s_mov_b32 s59, 400000
L_w_79:
    ds_read_b32 v22, v21
    s_sub_u32 s59, s59, 1
    s_waitcnt lgkmcnt(0)
    v_readfirstlane_b32 s69, v22
    s_cselect_b32 s69, 64, s69
    s_cmp_lt_i32 s69, 36
    s_cbranch_scc1 L_w_79

L_ws_80:
    s_mov_b32 s59, 400007
L_poll_81:
    s_and_b32 s60, s59, 7
    s_cbranch_scc1 L_nlz_84
    s_mov_b64 vcc, exec
    s_mov_b64 exec, 0x11
    s_add_u32 s60, s57, 2097152
    buffer_store_dwordx4 v[76:79], v90, s[28:31], s60 offen offset:0 sc1
    s_mov_b64 exec, -1
    s_mov_b64 exec, vcc
L_nlz_84:
    s_and_b32 s60, s59, 7
    s_cselect_b32 s60, 0, 2097152
    s_add_u32 s60, s60, s58
    buffer_load_dwordx4 v[68:71], v89, s[28:31], s60 offen offset:0 sc1
L_pchk_82:
    s_waitcnt vmcnt(0)
    v_xor_b32 v14, s49, v68
    v_xor_b32 v15, s50, v69
    v_or_b32 v16, v14, v15
    v_xor_b32 v14, s51, v70
    v_xor_b32 v15, s52, v71
    v_or3_b32 v16, v14, v15, v16
    v_and_b32 v16, 0x3ff, v16
    v_cmp_ne_u32 vcc, 0, v16
    s_sub_u32 s59, s59, 1
    s_cbranch_scc1 L_pdone_83
    s_and_b64 exec, exec, vcc
    s_cbranch_scc1 L_poll_81
L_pdone_83:
    s_mov_b64 exec, -1
    v_and_b32 v68, v20, v68
    v_and_b32 v69, v20, v69
    v_and_b32 v70, v20, v70
    v_and_b32 v71, v20, v71
    v_mov_b32 v80, v68
    v_mov_b32 v81, v69
    s_nop 1
    v_max_f32_dpp v80, v80, v80 row_ror:8 row_mask:0xf bank_mask:0xf
    s_nop 1
    v_max_f32_dpp v81, v81, v81 row_ror:8 row_mask:0xf bank_mask:0xf
    s_nop 1
    v_max_f32_dpp v80, v80, v80 row_ror:4 row_mask:0xf bank_mask:0xf
    s_nop 1
    v_max_f32_dpp v81, v81, v81 row_ror:4 row_mask:0xf bank_mask:0xf
    s_nop 1
    v_max_f32_dpp v80, v80, v80 row_ror:2 row_mask:0xf bank_mask:0xf
    s_nop 1
    v_max_f32_dpp v81, v81, v81 row_ror:2 row_mask:0xf bank_mask:0xf
    v_sub_f32 v68, v68, v80
    v_mul_f32 v68, 0x3fb8aa3b, v68
    v_exp_f32 v68, v68
    s_nop 0
    v_mul_f32 v70, v68, v70
    v_sub_f32 v69, v69, v81
    v_mul_f32 v69, 0x3fb8aa3b, v69
    v_exp_f32 v69, v69
    s_nop 0
    v_mul_f32 v71, v69, v71
    s_nop 1
    v_add_f32_dpp v70, v70, v70 row_ror:8 row_mask:0xf bank_mask:0xf
    s_nop 1
    v_add_f32_dpp v71, v71, v71 row_ror:8 row_mask:0xf bank_mask:0xf
    s_nop 1
    v_add_f32_dpp v70, v70, v70 row_ror:4 row_mask:0xf bank_mask:0xf
    s_nop 1
    v_add_f32_dpp v71, v71, v71 row_ror:4 row_mask:0xf bank_mask:0xf
    s_nop 1
    v_add_f32_dpp v70, v70, v70 row_ror:2 row_mask:0xf bank_mask:0xf
    s_nop 1
    v_add_f32_dpp v71, v71, v71 row_ror:2 row_mask:0xf bank_mask:0xf
    v_rcp_f32 v70, v70
    v_rcp_f32 v71, v71
    s_nop 0
    v_mul_f32 v68, v68, v70
    v_mul_f32 v69, v69, v71
    ds_write_b64 v86, v[68:69]
    v_mov_b32 v21, 163608
    s_mov_b64 exec, 1
    ds_add_u32 v21, v19
    s_mov_b64 exec, -1
    s_mov_b64 exec, 0x11
    s_add_u32 s60, s57, 2097152
    buffer_store_dwordx4 v[76:79], v90, s[28:31], s60 offen offset:0 sc1
    s_mov_b64 exec, -1
    s_mul_i32 s40, s68, 36864
    s_lshl_b32 s60, s64, 5
    s_add_u32 s40, s40, s60
    s_add_u32 s40, s40, 1310720
    v_lshrrev_b32 v14, 1, v8
    v_and_b32 v15, 1, v8
    v_mul_u32_u24 v85, 1152, v14
    v_lshl_add_u32 v85, v15, 4, v85
    v_lshlrev_b32 v28, 16, v28
    v_cmp_gt_u32 s[70:71], 2, v10
    v_mov_b32 v21, 163624
    s_mov_b32 s59, 400000
L_w_85:
    ds_read_b32 v22, v21
    s_sub_u32 s59, s59, 1
    s_waitcnt lgkmcnt(0)
    v_readfirstlane_b32 s56, v22
    s_cselect_b32 s56, 64, s56
    s_cmp_lt_i32 s56, 4
    s_cbranch_scc1 L_w_85

    s_mov_b32 s59, 400000
L_poll_87:
    buffer_load_dwordx4 v[68:71], v85, s[28:31], s40 offen offset:0 sc1
    s_waitcnt vmcnt(0)
L_pchk_88:
    v_xor_b32 v14, s49, v68
    v_xor_b32 v15, s50, v69
    v_or_b32 v16, v14, v15
    v_xor_b32 v14, s51, v70
    v_xor_b32 v15, s52, v71
    v_or3_b32 v16, v14, v15, v16
    v_and_b32 v16, 0x3ff, v16
    v_cmp_ne_u32 vcc, 0, v16
    s_sub_u32 s59, s59, 1
    s_cbranch_scc1 L_pdone_89
    s_and_b64 exec, exec, vcc
    s_cbranch_scc1 L_poll_87
L_pdone_89:
    s_mov_b64 exec, -1
    v_and_or_b32 v68, v68, v20, s53
    v_and_or_b32 v69, v69, v20, s53
    v_and_or_b32 v70, v70, v20, s53
    v_and_or_b32 v71, v71, v20, s53
    s_nop 1
    v_permlane32_swap_b32 v68, v70
    v_permlane32_swap_b32 v69, v71
    v_add_f32 v68, v68, v70
    v_add_f32 v69, v69, v71
    s_nop 1
    v_permlane16_swap_b32 v68, v69
    v_add_f32 v68, v68, v69

    s_nop 1
    v_add_f32_dpp v68, v68, v68 row_ror:8 row_mask:0xf bank_mask:0xf
    s_nop 1
    v_add_f32_dpp v68, v68, v68 row_ror:4 row_mask:0xf bank_mask:0xf
    s_nop 1
    v_add_f32_dpp v68, v68, v68 row_ror:2 row_mask:0xf bank_mask:0xf
    v_cvt_pk_bf16_f32 v68, v68, v68
    v_and_b32 v68, 0xffff0000, v68
    v_mov_b32 v21, 163616
    s_mov_b32 s59, 400000
L_w_90:
    ds_read_b32 v22, v21
    s_sub_u32 s59, s59, 1
    s_waitcnt lgkmcnt(0)
    v_readfirstlane_b32 s56, v22
    s_cselect_b32 s56, 64, s56
    s_cmp_lt_i32 s56, 1
    s_cbranch_scc1 L_w_90

    ds_read_b32 v88, v87
    s_waitcnt lgkmcnt(0)
    v_mul_f32 v68, v68, v88
    v_cvt_pk_bf16_f32 v68, v68, v68
    v_and_b32 v68, 0xffff0000, v68
    v_add_f32 v68, v68, v28
    v_cvt_pk_bf16_f32 v68, v68, v68
    s_mov_b64 exec, s[70:71]
    buffer_store_short v68, v29, s[36:39], 0 offen
    s_mov_b64 exec, 1
    s_cmp_lg_u32 s2, 0
    s_cbranch_scc1 L_end
    v_mov_b32 v14, s48
    v_mov_b32 v15, 0
    buffer_store_dword v14, v15, s[28:31], 0 offen sc1

L_end:
    s_endpgm
.section .rodata,"a"
.p2align 6
.amdhsa_kernel recurrent_scan__sliding_block_cached__swiglu_ffn__decode_kernel
  .amdhsa_next_free_vgpr 144
  .amdhsa_next_free_sgpr 102
  .amdhsa_accum_offset 144
  .amdhsa_group_segment_fixed_size 0
  .amdhsa_kernarg_size 96
  .amdhsa_user_sgpr_count 2
  .amdhsa_user_sgpr_kernarg_segment_ptr 1
  .amdhsa_system_sgpr_workgroup_id_x 1
  .amdhsa_float_denorm_mode_32 3
.end_amdhsa_kernel
```
